```python
import torch

def _softmax(x, axis=-1):
    return torch.softmax(x, dim=axis)
def _gelu(x):
    return torch.nn.functional.gelu(x, approximate="tanh")
def _silu(x):
    return torch.nn.functional.silu(x)
def _sigmoid(x):
    return torch.sigmoid(x)
def _layernorm(x, axis=-1, eps=1e-5):
    m = x.mean(dim=axis, keepdim=True)
    v = x.var(dim=axis, keepdim=True, unbiased=False)
    return (x - m) / torch.sqrt(v + eps)
def _scatter_add(tgt, idx, src, axis=0):
    return tgt.clone().index_add_(axis, idx, src)
def _segment_sum(src, seg, n):
    out = torch.zeros((n,) + src.shape[1:], dtype=src.dtype)
    return out.index_add_(0, seg, src)
def _pad(x, pw):
    flat = tuple(v for pair in reversed(pw) for v in pair)
    return torch.nn.functional.pad(x, flat)

kernel_name = 'standalone__w4a16_gemm_dequant__prompt'

def setup_inputs():

    _w = (lambda a: (lambda t: t.to(torch.bfloat16) if t.is_floating_point() else t)(torch.as_tensor(a)))
    B, S, D, F = 1, 2048, 1024, 3584
    G = 128 if 128 > 0 else D
    D = (D // G) * G
    ng = D // G
    qw = torch.randint(0, 16, (D, F)).to(torch.int32)
    return {
        "x": _w((lambda *s: torch.randn(*s, dtype=torch.bfloat16) * 0.05)(B, S, D)),
        "qw": _w(qw),
        "scales": _w(torch.abs((lambda *s: torch.randn(*s, dtype=torch.bfloat16) * 0.05)(ng, F)) + 0.01),
        "zeros": _w(torch.full((ng, F), 8.0, dtype=float)),
    }

def reference(x, qw, scales, zeros):
    B, S, D = x.shape
    ng, F = scales.shape
    G = D // ng
    s = (lambda x, n, axis: torch.repeat_interleave(x, n, dim=axis))(scales, G, axis=0)
    z = (lambda x, n, axis: torch.repeat_interleave(x, n, dim=axis))(zeros, G, axis=0)
    w = ((lambda x, dt: x.to(dt))(qw, x.dtype) - z) * s
    return x @ w
```

```asm
; @launch grid=(256,1,1) block=(512,1,1) lds=155648
.amdgcn_target "amdgcn-amd-amdhsa--gfx950"
.text
.globl standalone__w4a16_gemm_dequant__prompt_kernel
.p2align 8
.type standalone__w4a16_gemm_dequant__prompt_kernel,@function
standalone__w4a16_gemm_dequant__prompt_kernel:
    s_cmp_ge_u32 s2, 256
    s_cbranch_scc1 L_end
    s_load_dwordx8 s[40:47], s[0:1], 0
    s_load_dwordx4 s[48:51], s[0:1], 32
    s_load_dwordx2 s[52:53], s[0:1], 48
    s_getpc_b64 s[90:91]
    v_lshlrev_b32 v4, 7, v0
    v_mov_b32 v3, s91
    v_add_co_u32 v2, vcc, s90, v4
    s_nop 1
    v_addc_co_u32 v3, vcc, 0, v3, vcc
    v_cmp_gt_u32 vcc, 6144, v4
    s_and_saveexec_b64 s[92:93], vcc
    s_cbranch_execz L_nocpf
    global_load_dword v255, v[2:3], off
L_nocpf:
    s_mov_b64 exec, s[92:93]
    s_memrealtime s[54:55]
    s_and_b32 s24, s2, 7
    s_lshr_b32 s25, s2, 3
    s_and_b32 s26, s25, 3
    s_lshl_b32 s24, s24, 2
    s_add_u32 s33, s24, s26
    s_lshr_b32 s39, s25, 2
    s_and_b32 s24, s2, 1
    s_lshl_b32 s24, s24, 2
    s_bfe_u32 s25, s2, 0x20003
    s_add_u32 s39, s24, s25
    s_bfe_u32 s24, s2, 0x20001
    s_lshl_b32 s24, s24, 3
    s_lshr_b32 s25, s2, 5
    s_add_u32 s33, s24, s25
    s_mul_i32 s36, s33, 112
    s_lshl_b32 s35, s39, 8
    v_lshrrev_b32 v1, 6, v0
    v_and_b32 v10, 255, v0
    v_readfirstlane_b32 s31, v1
    v_lshrrev_b32 v11, 5, v10
    v_and_b32 v12, 31, v10
    v_min_u32 v12, 27, v12
    s_lshl_b32 s28, s36, 2
    v_lshl_add_u32 v14, v12, 4, s28
    v_lshrrev_b32 v92, 1, v14
    s_mov_b32 s27, 114688
    v_mul_lo_u32 v13, v11, s27
    v_add_u32 v24, v14, v13
    v_add_u32 v25, 14336, v24
    v_add_u32 v26, 28672, v24
    v_add_u32 v27, 43008, v24
    v_add_u32 v28, 57344, v24
    v_add_u32 v29, 71680, v24
    v_add_u32 v30, 86016, v24
    v_add_u32 v31, 100352, v24
    s_mov_b32 s34, 0x4b800000
    s_and_b32 s37, s31, 3
    s_lshr_b32 s26, s31, 2
    s_lshl_b32 s97, s39, 1
    s_add_u32 s25, s97, s26
    s_mul_i32 s78, s25, 917504
    s_mul_i32 s79, s26, 14336
    s_mul_i32 s80, s39, 7168
    s_lshl_b32 s24, s33, 4
    s_add_u32 s24, s24, s25
    s_mul_i32 s30, s24, 14336
    s_lshl_b32 s24, s24, 2
    s_add_u32 s24, s24, s37
    s_lshl_b32 s24, s24, 7
    s_add_u32 s74, s24, 8388608
    s_lshl_b32 s24, s33, 2
    v_mov_b32 v241, s24
    s_or_b32 s25, s31, s39
    s_cmp_eq_u32 s25, 0
    s_cselect_b32 s24, s24, 0x1000
    v_mov_b32 v82, s24
    s_waitcnt lgkmcnt(0)
    s_mov_b32 s16, s44
    s_and_b32 s17, s45, 0xffff
    s_mov_b32 s18, 57344
    s_mov_b32 s19, 0x00020000
    s_mov_b32 s20, s46
    s_and_b32 s21, s47, 0xffff
    s_mov_b32 s22, 57344
    s_mov_b32 s23, 0x00020000
    s_mov_b32 s8, s42
    s_and_b32 s9, s43, 0xffff
    s_mov_b32 s10, 14680064
    s_mov_b32 s11, 0x00020000
    buffer_load_dwordx2 v[96:97], v92, s[16:19], s80 offen
    buffer_load_dwordx2 v[98:99], v92, s[20:23], s80 offen
    buffer_load_dwordx4 v[100:103], v24, s[8:11], s78 offen nt
    buffer_load_dwordx4 v[104:107], v25, s[8:11], s78 offen nt
    buffer_load_dwordx4 v[108:111], v26, s[8:11], s78 offen nt
    buffer_load_dwordx4 v[112:115], v27, s[8:11], s78 offen nt
    buffer_load_dwordx4 v[116:119], v28, s[8:11], s78 offen nt
    buffer_load_dwordx4 v[120:123], v29, s[8:11], s78 offen nt
    buffer_load_dwordx4 v[124:127], v30, s[8:11], s78 offen nt
    buffer_load_dwordx4 v[128:131], v31, s[8:11], s78 offen nt
    s_mov_b32 s84, s50
    s_and_b32 s85, s51, 0xffff
    s_mov_b32 s86, 256
    s_mov_b32 s87, 0x00020000
    s_or_b32 s54, s54, 1
    v_mov_b32 v83, s54
    s_mov_b64 exec, 1
    buffer_store_dword v83, v82, s[84:87], 0 offen sc1
    s_mov_b64 exec, -1
    s_mov_b32 s4, s40
    s_and_b32 s5, s41, 0xffff
    s_mov_b32 s6, 4194304
    s_mov_b32 s7, 0x00020000
    s_mov_b32 s12, s48
    s_and_b32 s13, s49, 0xffff
    s_mov_b32 s14, 14680064
    s_mov_b32 s15, 0x00020000
    s_mov_b32 s64, s52
    s_and_b32 s65, s53, 0xffff
    s_mov_b32 s66, 8650752
    s_mov_b32 s67, 0x00020000
    v_and_b32 v77, 63, v0
    v_bfe_u32 v79, v0, 4, 2
    v_and_b32 v78, 3, v1
    v_lshrrev_b32 v84, 3, v77
    v_lshl_add_u32 v84, v78, 6, v84
    v_add_u32 v84, s35, v84
    v_lshlrev_b32 v84, 11, v84
    v_and_b32 v85, 7, v77
    v_xor_b32 v85, v85, v79
    v_xor_b32 v86, 4, v85
    v_lshl_add_u32 v85, v85, 4, v84
    v_lshl_add_u32 v86, v86, 4, v84
    v_add_u32 v16, 0, v85
    v_add_u32 v17, 15360, v86
    v_add_u32 v18, 30720, v85
    v_add_u32 v19, 46080, v86
    v_add_u32 v20, 65536, v85
    v_add_u32 v21, 80896, v86
    v_add_u32 v22, 96256, v85
    v_add_u32 v23, 111616, v86
    s_lshl_b32 s38, s37, 13
    s_lshr_b32 s26, s31, 2
    s_add_u32 s29, s97, s26
    s_lshl_b32 s29, s29, 7
    s_lshl_b32 s28, s26, 15
    v_lshrrev_b32 v84, 2, v12
    v_and_b32 v85, 3, v12
    v_and_b32 v86, 1, v84
    v_lshlrev_b32 v86, 1, v86
    v_lshrrev_b32 v87, 1, v85
    v_add_u32 v86, v86, v87
    v_lshlrev_b32 v84, 8, v84
    v_lshl_add_u32 v84, v85, 6, v84
    v_mul_u32_u24 v88, 1792, v11
    v_add_u32 v88, v88, v84
    v_add_u32 v88, 98304, v88
    v_xor_b32 v87, 0, v86
    v_lshl_add_u32 v60, v87, 4, v88
    v_xor_b32 v87, 1, v86
    v_lshl_add_u32 v61, v87, 4, v88
    v_xor_b32 v87, 2, v86
    v_lshl_add_u32 v62, v87, 4, v88
    v_xor_b32 v87, 3, v86
    v_lshl_add_u32 v63, v87, 4, v88
    v_lshlrev_b32 v236, 4, v77
    s_mul_i32 s24, s37, 3584
    s_add_u32 s30, s30, s24
    s_mul_i32 s70, s33, 229376
    s_add_u32 s70, s70, s24
    s_add_u32 s71, s24, 98304
    s_add_u32 s24, s71, s79
    v_add_u32 v90, s24, v236
    v_mov_b32 v240, 0
    s_waitcnt vmcnt(1)
    s_call_b64 s[76:77], L_dq
    s_cmp_ge_u32 s31, 4
    s_cbranch_scc1 L_prod
    ds_read_b128 v[40:43], v90 offset:0
    ds_read_b128 v[44:47], v90 offset:1024
    ds_read_b128 v[48:51], v90 offset:2048
    ds_read_b128 v[52:55], v90 offset:3072
    s_waitcnt lgkmcnt(3)
    buffer_store_dwordx4 v[40:43], v236, s[64:67], s30 offen offset:0 sc1
    s_waitcnt lgkmcnt(2)
    buffer_store_dwordx4 v[44:47], v236, s[64:67], s30 offen offset:1024 sc1
    s_waitcnt lgkmcnt(1)
    buffer_store_dwordx4 v[48:51], v236, s[64:67], s30 offen offset:2048 sc1
    s_waitcnt lgkmcnt(0)
    s_mov_b32 exec_hi, 0
    buffer_store_dwordx4 v[52:55], v236, s[64:67], s30 offen offset:3072 sc1
    s_mov_b32 exec_hi, -1
    buffer_load_dword v238, v241, s[84:87], 0 offen sc1
    s_add_u32 s24, s38, s28
    s_add_u32 m0, s24, 0
    s_nop 0
    buffer_load_dwordx4 v16, s[4:7], s29 offen offset:0 lds
    buffer_load_dwordx4 v17, s[4:7], s29 offen offset:1024 lds
    buffer_load_dwordx4 v18, s[4:7], s29 offen offset:2048 lds
    buffer_load_dwordx4 v19, s[4:7], s29 offen offset:3072 lds
    s_add_u32 m0, s24, 4096
    s_nop 0
    buffer_load_dwordx4 v20, s[4:7], s29 offen offset:0 lds
    buffer_load_dwordx4 v21, s[4:7], s29 offen offset:1024 lds
    buffer_load_dwordx4 v22, s[4:7], s29 offen offset:2048 lds
    buffer_load_dwordx4 v23, s[4:7], s29 offen offset:3072 lds
    v_and_b32 v14, 15, v0
    v_bfe_u32 v15, v0, 4, 2
    v_lshrrev_b32 v10, 3, v14
    v_xor_b32 v10, v10, v14
    v_mul_u32_u24 v11, 1792, v15
    v_add_u32 v11, 98304, v11
    v_lshl_add_u32 v2, v10, 4, v11
    v_xor_b32 v10, 2, v10
    v_lshl_add_u32 v3, v10, 4, v11
    v_lshrrev_b32 v10, 1, v14
    v_xor_b32 v10, v10, v15
    v_lshlrev_b32 v11, 13, v1
    v_lshl_add_u32 v11, v14, 7, v11
    v_lshl_add_u32 v4, v10, 4, v11
    v_xor_b32 v5, 64, v4
    v_mov_b64 v[16:17], 0
    v_mov_b64 v[18:19], 0
    v_mov_b64 v[20:21], 0
    v_mov_b64 v[22:23], 0
    v_mov_b64 v[24:25], 0
    v_mov_b64 v[26:27], 0
    v_mov_b64 v[28:29], 0
    v_mov_b64 v[30:31], 0
    v_mov_b64 v[32:33], 0
    v_mov_b64 v[34:35], 0
    v_mov_b64 v[36:37], 0
    v_mov_b64 v[38:39], 0
    v_mov_b64 v[56:57], 0
    v_mov_b64 v[58:59], 0
    v_mov_b64 v[60:61], 0
    v_mov_b64 v[62:63], 0
    v_mov_b64 v[64:65], 0
    v_mov_b64 v[66:67], 0
    v_mov_b64 v[68:69], 0
    v_mov_b64 v[70:71], 0
    v_mov_b64 v[72:73], 0
    v_mov_b64 v[74:75], 0
    v_mov_b64 v[76:77], 0
    v_mov_b64 v[78:79], 0
    v_mov_b64 v[80:81], 0
    v_mov_b64 v[82:83], 0
    v_mov_b64 v[84:85], 0
    v_mov_b64 v[86:87], 0
    v_mov_b64 v[88:89], 0
    v_mov_b64 v[90:91], 0
    v_mov_b64 v[92:93], 0
    v_mov_b64 v[94:95], 0
    v_mov_b64 v[96:97], 0
    v_mov_b64 v[98:99], 0
    v_mov_b64 v[100:101], 0
    v_mov_b64 v[102:103], 0
    v_mov_b64 v[104:105], 0
    v_mov_b64 v[106:107], 0
    v_mov_b64 v[108:109], 0
    v_mov_b64 v[110:111], 0
    v_mov_b64 v[112:113], 0
    v_mov_b64 v[114:115], 0
    v_mov_b64 v[116:117], 0
    v_mov_b64 v[118:119], 0
    v_mov_b64 v[120:121], 0
    v_mov_b64 v[122:123], 0
    v_mov_b64 v[124:125], 0
    v_mov_b64 v[126:127], 0
    v_mov_b64 v[156:157], 0
    v_mov_b64 v[158:159], 0
    v_mov_b64 v[160:161], 0
    v_mov_b64 v[162:163], 0
    v_mov_b64 v[164:165], 0
    v_mov_b64 v[166:167], 0
    v_mov_b64 v[168:169], 0
    v_mov_b64 v[170:171], 0
    v_mov_b64 v[172:173], 0
    v_mov_b64 v[174:175], 0
    v_mov_b64 v[176:177], 0
    v_mov_b64 v[178:179], 0
    v_mov_b64 v[180:181], 0
    v_mov_b64 v[182:183], 0
    v_mov_b64 v[200:201], 0
    v_mov_b64 v[202:203], 0
    v_mov_b64 v[204:205], 0
    v_mov_b64 v[206:207], 0
    v_mov_b64 v[208:209], 0
    v_mov_b64 v[210:211], 0
    v_mov_b64 v[212:213], 0
    v_mov_b64 v[214:215], 0
    s_mov_b32 s94, 0
    s_mov_b32 s95, 0
    s_mov_b32 s96, 0
    v_mov_b32 v9, v4
    v_mov_b32 v10, v5
    v_mov_b32 v11, v2
    v_mov_b32 v12, v3
    s_waitcnt vmcnt(8)
    v_mov_b64 v[40:41], 0
    v_mov_b64 v[42:43], 0
    v_mov_b64 v[44:45], 0
    v_mov_b64 v[46:47], 0
    v_mov_b64 v[48:49], 0
    v_mov_b64 v[50:51], 0
    v_mov_b64 v[52:53], 0
    v_mov_b64 v[54:55], 0
    v_readfirstlane_b32 s82, v238
    s_cmp_lg_u32 s82, 0
    s_cbranch_scc1 L_n_gotc
    s_mov_b32 s81, 0
L_n_pollc:
    buffer_load_dword v238, v241, s[84:87], 0 offen sc1
    s_waitcnt vmcnt(0)
    v_readfirstlane_b32 s82, v238
    s_cmp_lg_u32 s82, 0
    s_cbranch_scc1 L_n_gotc
    s_sleep 2
    s_add_u32 s81, s81, 1
    s_cmp_lt_u32 s81, 64
    s_cbranch_scc1 L_n_pollc
L_n_gotc:
    s_mov_b64 exec, 1
    buffer_store_dword v238, v240, s[64:67], s74 offen sc1
    s_mov_b64 exec, -1
    v_bfe_u32 v248, v0, 3, 3
    s_lshl_b32 s24, s33, 3
    s_add_u32 s24, s24, s35
    v_add_u32 v248, s24, v248
    v_lshlrev_b32 v248, 11, v248
    v_and_b32 v249, 7, v0
    v_lshl_add_u32 v248, v249, 4, v248
    v_lshl_add_u32 v248, v1, 7, v248
    s_mov_b32 s24, 0
    buffer_load_dwordx4 v[244:247], v248, s[4:7], s24 offen
    s_mov_b32 s24, 512
    buffer_load_dwordx4 v[244:247], v248, s[4:7], s24 offen
    s_mov_b32 s24, 1024
    buffer_load_dwordx4 v[244:247], v248, s[4:7], s24 offen
    s_mov_b32 s24, 1536
    buffer_load_dwordx4 v[244:247], v248, s[4:7], s24 offen
    s_setprio 3
    s_waitcnt vmcnt(5)
L_cloop:
    s_barrier
    ds_read_b128 v[184:187], v9 offset:0
    ds_read_b128 v[188:191], v9 offset:2048
    ds_read_b128 v[192:195], v9 offset:4096
    v_mfma_f32_16x16x32_bf16 v[80:83], v[172:175], v[200:203], v[80:83]
    ds_read_b128 v[196:199], v9 offset:6144
    v_mfma_f32_16x16x32_bf16 v[84:87], v[172:175], v[204:207], v[84:87]
    ds_read_b128 v[128:131], v11 offset:0
    v_mfma_f32_16x16x32_bf16 v[88:91], v[172:175], v[208:211], v[88:91]
    ds_read_b128 v[132:135], v12 offset:256
    v_mfma_f32_16x16x32_bf16 v[92:95], v[172:175], v[212:215], v[92:95]
    ds_read_b128 v[136:139], v11 offset:512
    v_mfma_f32_16x16x32_bf16 v[96:99], v[176:179], v[200:203], v[96:99]
    ds_read_b128 v[140:143], v12 offset:768
    v_mfma_f32_16x16x32_bf16 v[100:103], v[176:179], v[204:207], v[100:103]
    ds_read_b128 v[144:147], v11 offset:1024
    v_mfma_f32_16x16x32_bf16 v[104:107], v[176:179], v[208:211], v[104:107]
    ds_read_b128 v[148:151], v12 offset:1280
    v_mfma_f32_16x16x32_bf16 v[108:111], v[176:179], v[212:215], v[108:111]
    ds_read_b128 v[152:155], v11 offset:1536
    v_mfma_f32_16x16x32_bf16 v[112:115], v[180:183], v[200:203], v[112:115]
    v_mfma_f32_16x16x32_bf16 v[116:119], v[180:183], v[204:207], v[116:119]
    v_mfma_f32_16x16x32_bf16 v[120:123], v[180:183], v[208:211], v[120:123]
    v_mfma_f32_16x16x32_bf16 v[124:127], v[180:183], v[212:215], v[124:127]
    s_waitcnt lgkmcnt(0)
    v_mfma_f32_16x16x32_bf16 v[16:19], v[128:131], v[184:187], v[16:19]
    ds_read_b128 v[200:203], v10 offset:0
    v_mfma_f32_16x16x32_bf16 v[20:23], v[128:131], v[188:191], v[20:23]
    ds_read_b128 v[204:207], v10 offset:2048
    v_mfma_f32_16x16x32_bf16 v[24:27], v[128:131], v[192:195], v[24:27]
    ds_read_b128 v[208:211], v10 offset:4096
    v_mfma_f32_16x16x32_bf16 v[28:31], v[128:131], v[196:199], v[28:31]
    ds_read_b128 v[212:215], v10 offset:6144
    v_mfma_f32_16x16x32_bf16 v[32:35], v[132:135], v[184:187], v[32:35]
    ds_read_b128 v[156:159], v11 offset:7168
    v_mfma_f32_16x16x32_bf16 v[36:39], v[132:135], v[188:191], v[36:39]
    ds_read_b128 v[160:163], v12 offset:7424
    v_mfma_f32_16x16x32_bf16 v[40:43], v[132:135], v[192:195], v[40:43]
    ds_read_b128 v[164:167], v11 offset:7680
    v_mfma_f32_16x16x32_bf16 v[44:47], v[132:135], v[196:199], v[44:47]
    ds_read_b128 v[168:171], v12 offset:7936
    v_mfma_f32_16x16x32_bf16 v[48:51], v[136:139], v[184:187], v[48:51]
    ds_read_b128 v[172:175], v11 offset:8192
    v_mfma_f32_16x16x32_bf16 v[52:55], v[136:139], v[188:191], v[52:55]
    ds_read_b128 v[176:179], v12 offset:8448
    v_mfma_f32_16x16x32_bf16 v[56:59], v[136:139], v[192:195], v[56:59]
    ds_read_b128 v[180:183], v11 offset:8704
    v_mfma_f32_16x16x32_bf16 v[60:63], v[136:139], v[196:199], v[60:63]
    v_mfma_f32_16x16x32_bf16 v[64:67], v[140:143], v[184:187], v[64:67]
    v_mfma_f32_16x16x32_bf16 v[68:71], v[140:143], v[188:191], v[68:71]
    v_mfma_f32_16x16x32_bf16 v[72:75], v[140:143], v[192:195], v[72:75]
    v_mfma_f32_16x16x32_bf16 v[76:79], v[140:143], v[196:199], v[76:79]
    v_mfma_f32_16x16x32_bf16 v[80:83], v[144:147], v[184:187], v[80:83]
    v_mfma_f32_16x16x32_bf16 v[84:87], v[144:147], v[188:191], v[84:87]
    v_mfma_f32_16x16x32_bf16 v[88:91], v[144:147], v[192:195], v[88:91]
    v_mfma_f32_16x16x32_bf16 v[92:95], v[144:147], v[196:199], v[92:95]
    v_mfma_f32_16x16x32_bf16 v[96:99], v[148:151], v[184:187], v[96:99]
    v_mfma_f32_16x16x32_bf16 v[100:103], v[148:151], v[188:191], v[100:103]
    v_mfma_f32_16x16x32_bf16 v[104:107], v[148:151], v[192:195], v[104:107]
    v_mfma_f32_16x16x32_bf16 v[108:111], v[148:151], v[196:199], v[108:111]
    v_mfma_f32_16x16x32_bf16 v[112:115], v[152:155], v[184:187], v[112:115]
    v_mfma_f32_16x16x32_bf16 v[116:119], v[152:155], v[188:191], v[116:119]
    v_mfma_f32_16x16x32_bf16 v[120:123], v[152:155], v[192:195], v[120:123]
    v_mfma_f32_16x16x32_bf16 v[124:127], v[152:155], v[196:199], v[124:127]
    s_waitcnt lgkmcnt(0)
    v_mfma_f32_16x16x32_bf16 v[16:19], v[156:159], v[200:203], v[16:19]
    s_add_u32 s94, s94, 32768
    v_mfma_f32_16x16x32_bf16 v[20:23], v[156:159], v[204:207], v[20:23]
    s_cmp_eq_u32 s94, 98304
    v_mfma_f32_16x16x32_bf16 v[24:27], v[156:159], v[208:211], v[24:27]
    s_cselect_b32 s94, 0, s94
    v_mfma_f32_16x16x32_bf16 v[28:31], v[156:159], v[212:215], v[28:31]
    s_add_u32 s95, s95, 14336
    v_mfma_f32_16x16x32_bf16 v[32:35], v[160:163], v[200:203], v[32:35]
    s_cmp_eq_u32 s95, 57344
    v_mfma_f32_16x16x32_bf16 v[36:39], v[160:163], v[204:207], v[36:39]
    s_cselect_b32 s95, 0, s95
    v_mfma_f32_16x16x32_bf16 v[40:43], v[160:163], v[208:211], v[40:43]
    v_add_u32 v9, s94, v4
    v_mfma_f32_16x16x32_bf16 v[44:47], v[160:163], v[212:215], v[44:47]
    v_add_u32 v10, s94, v5
    v_mfma_f32_16x16x32_bf16 v[48:51], v[164:167], v[200:203], v[48:51]
    v_add_u32 v11, s95, v2
    v_mfma_f32_16x16x32_bf16 v[52:55], v[164:167], v[204:207], v[52:55]
    v_add_u32 v12, s95, v3
    v_mfma_f32_16x16x32_bf16 v[56:59], v[164:167], v[208:211], v[56:59]
    s_add_u32 s96, s96, 1
    v_mfma_f32_16x16x32_bf16 v[60:63], v[164:167], v[212:215], v[60:63]
    v_mfma_f32_16x16x32_bf16 v[64:67], v[168:171], v[200:203], v[64:67]
    v_mfma_f32_16x16x32_bf16 v[68:71], v[168:171], v[204:207], v[68:71]
    s_cmp_lt_u32 s96, 15
    v_mfma_f32_16x16x32_bf16 v[72:75], v[168:171], v[208:211], v[72:75]
    v_mfma_f32_16x16x32_bf16 v[76:79], v[168:171], v[212:215], v[76:79]
    s_cbranch_scc1 L_cloop
    s_barrier
    ds_read_b128 v[184:187], v9 offset:0
    ds_read_b128 v[188:191], v9 offset:2048
    ds_read_b128 v[192:195], v9 offset:4096
    v_mfma_f32_16x16x32_bf16 v[80:83], v[172:175], v[200:203], v[80:83]
    ds_read_b128 v[196:199], v9 offset:6144
    v_mfma_f32_16x16x32_bf16 v[84:87], v[172:175], v[204:207], v[84:87]
    ds_read_b128 v[128:131], v11 offset:0
    v_mfma_f32_16x16x32_bf16 v[88:91], v[172:175], v[208:211], v[88:91]
    ds_read_b128 v[132:135], v12 offset:256
    v_mfma_f32_16x16x32_bf16 v[92:95], v[172:175], v[212:215], v[92:95]
    ds_read_b128 v[136:139], v11 offset:512
    v_mfma_f32_16x16x32_bf16 v[96:99], v[176:179], v[200:203], v[96:99]
    ds_read_b128 v[140:143], v12 offset:768
    v_mfma_f32_16x16x32_bf16 v[100:103], v[176:179], v[204:207], v[100:103]
    ds_read_b128 v[144:147], v11 offset:1024
    v_mfma_f32_16x16x32_bf16 v[104:107], v[176:179], v[208:211], v[104:107]
    ds_read_b128 v[148:151], v12 offset:1280
    v_mfma_f32_16x16x32_bf16 v[108:111], v[176:179], v[212:215], v[108:111]
    ds_read_b128 v[152:155], v11 offset:1536
    v_mfma_f32_16x16x32_bf16 v[112:115], v[180:183], v[200:203], v[112:115]
    v_mfma_f32_16x16x32_bf16 v[116:119], v[180:183], v[204:207], v[116:119]
    v_mfma_f32_16x16x32_bf16 v[120:123], v[180:183], v[208:211], v[120:123]
    v_mfma_f32_16x16x32_bf16 v[124:127], v[180:183], v[212:215], v[124:127]
    ds_read_b128 v[200:203], v10 offset:0
    ds_read_b128 v[204:207], v10 offset:2048
    ds_read_b128 v[208:211], v10 offset:4096
    ds_read_b128 v[212:215], v10 offset:6144
    ds_read_b128 v[156:159], v11 offset:7168
    ds_read_b128 v[160:163], v12 offset:7424
    ds_read_b128 v[164:167], v11 offset:7680
    ds_read_b128 v[168:171], v12 offset:7936
    ds_read_b128 v[172:175], v11 offset:8192
    ds_read_b128 v[176:179], v12 offset:8448
    ds_read_b128 v[180:183], v11 offset:8704
    s_mov_b32 s27, 240
    v_lshl_add_u32 v13, v1, 6, v14
    v_mul_lo_u32 v13, v13, s27
    v_lshl_add_u32 v13, v15, 3, v13
    v_add_u32 v13, 32768, v13
    s_waitcnt lgkmcnt(11)
    v_mfma_f32_16x16x32_bf16 v[16:19], v[128:131], v[184:187], v[16:19]
    v_mfma_f32_16x16x32_bf16 v[32:35], v[132:135], v[184:187], v[32:35]
    v_mfma_f32_16x16x32_bf16 v[48:51], v[136:139], v[184:187], v[48:51]
    v_mfma_f32_16x16x32_bf16 v[64:67], v[140:143], v[184:187], v[64:67]
    v_mfma_f32_16x16x32_bf16 v[80:83], v[144:147], v[184:187], v[80:83]
    v_mfma_f32_16x16x32_bf16 v[96:99], v[148:151], v[184:187], v[96:99]
    v_mfma_f32_16x16x32_bf16 v[112:115], v[152:155], v[184:187], v[112:115]
    s_waitcnt lgkmcnt(0)
    v_mfma_f32_16x16x32_bf16 v[16:19], v[156:159], v[200:203], v[16:19]
    v_mfma_f32_16x16x32_bf16 v[32:35], v[160:163], v[200:203], v[32:35]
    v_mfma_f32_16x16x32_bf16 v[48:51], v[164:167], v[200:203], v[48:51]
    v_mfma_f32_16x16x32_bf16 v[64:67], v[168:171], v[200:203], v[64:67]
    v_mfma_f32_16x16x32_bf16 v[80:83], v[172:175], v[200:203], v[80:83]
    v_mfma_f32_16x16x32_bf16 v[96:99], v[176:179], v[200:203], v[96:99]
    v_mfma_f32_16x16x32_bf16 v[112:115], v[180:183], v[200:203], v[112:115]
    v_mfma_f32_16x16x32_bf16 v[20:23], v[128:131], v[188:191], v[20:23]
    v_mfma_f32_16x16x32_bf16 v[36:39], v[132:135], v[188:191], v[36:39]
    v_mfma_f32_16x16x32_bf16 v[52:55], v[136:139], v[188:191], v[52:55]
    v_cvt_pk_bf16_f32 v220, v16, v17
    v_cvt_pk_bf16_f32 v221, v18, v19
    v_mfma_f32_16x16x32_bf16 v[68:71], v[140:143], v[188:191], v[68:71]
    ds_write_b64 v13, v[220:221] offset:0
    v_cvt_pk_bf16_f32 v222, v32, v33
    v_mfma_f32_16x16x32_bf16 v[84:87], v[144:147], v[188:191], v[84:87]
    v_cvt_pk_bf16_f32 v223, v34, v35
    ds_write_b64 v13, v[222:223] offset:32
    v_mfma_f32_16x16x32_bf16 v[100:103], v[148:151], v[188:191], v[100:103]
    v_cvt_pk_bf16_f32 v224, v48, v49
    v_cvt_pk_bf16_f32 v225, v50, v51
    v_mfma_f32_16x16x32_bf16 v[116:119], v[152:155], v[188:191], v[116:119]
    ds_write_b64 v13, v[224:225] offset:64
    v_cvt_pk_bf16_f32 v226, v64, v65
    v_mfma_f32_16x16x32_bf16 v[20:23], v[156:159], v[204:207], v[20:23]
    v_cvt_pk_bf16_f32 v227, v66, v67
    ds_write_b64 v13, v[226:227] offset:96
    v_mfma_f32_16x16x32_bf16 v[36:39], v[160:163], v[204:207], v[36:39]
    v_cvt_pk_bf16_f32 v228, v80, v81
    v_cvt_pk_bf16_f32 v229, v82, v83
    v_mfma_f32_16x16x32_bf16 v[52:55], v[164:167], v[204:207], v[52:55]
    ds_write_b64 v13, v[228:229] offset:128
    v_cvt_pk_bf16_f32 v230, v96, v97
    v_mfma_f32_16x16x32_bf16 v[68:71], v[168:171], v[204:207], v[68:71]
    v_cvt_pk_bf16_f32 v231, v98, v99
    ds_write_b64 v13, v[230:231] offset:160
    v_mfma_f32_16x16x32_bf16 v[84:87], v[172:175], v[204:207], v[84:87]
    v_cvt_pk_bf16_f32 v232, v112, v113
    v_cvt_pk_bf16_f32 v233, v114, v115
    v_mfma_f32_16x16x32_bf16 v[100:103], v[176:179], v[204:207], v[100:103]
    ds_write_b64 v13, v[232:233] offset:192
    v_mfma_f32_16x16x32_bf16 v[116:119], v[180:183], v[204:207], v[116:119]
    s_waitcnt lgkmcnt(0)
    s_barrier
    v_mfma_f32_16x16x32_bf16 v[24:27], v[128:131], v[192:195], v[24:27]
    v_mfma_f32_16x16x32_bf16 v[40:43], v[132:135], v[192:195], v[40:43]
    v_mfma_f32_16x16x32_bf16 v[56:59], v[136:139], v[192:195], v[56:59]
    v_cvt_pk_bf16_f32 v220, v20, v21
    v_cvt_pk_bf16_f32 v221, v22, v23
    v_mfma_f32_16x16x32_bf16 v[72:75], v[140:143], v[192:195], v[72:75]
    ds_write_b64 v13, v[220:221] offset:3840
    v_cvt_pk_bf16_f32 v222, v36, v37
    v_mfma_f32_16x16x32_bf16 v[88:91], v[144:147], v[192:195], v[88:91]
    v_cvt_pk_bf16_f32 v223, v38, v39
    ds_write_b64 v13, v[222:223] offset:3872
    v_mfma_f32_16x16x32_bf16 v[104:107], v[148:151], v[192:195], v[104:107]
    v_cvt_pk_bf16_f32 v224, v52, v53
    v_cvt_pk_bf16_f32 v225, v54, v55
    v_mfma_f32_16x16x32_bf16 v[120:123], v[152:155], v[192:195], v[120:123]
    ds_write_b64 v13, v[224:225] offset:3904
    v_cvt_pk_bf16_f32 v226, v68, v69
    v_mfma_f32_16x16x32_bf16 v[24:27], v[156:159], v[208:211], v[24:27]
    v_cvt_pk_bf16_f32 v227, v70, v71
    ds_write_b64 v13, v[226:227] offset:3936
    v_mfma_f32_16x16x32_bf16 v[40:43], v[160:163], v[208:211], v[40:43]
    v_cvt_pk_bf16_f32 v228, v84, v85
    v_cvt_pk_bf16_f32 v229, v86, v87
    v_mfma_f32_16x16x32_bf16 v[56:59], v[164:167], v[208:211], v[56:59]
    ds_write_b64 v13, v[228:229] offset:3968
    v_cvt_pk_bf16_f32 v230, v100, v101
    v_mfma_f32_16x16x32_bf16 v[72:75], v[168:171], v[208:211], v[72:75]
    v_cvt_pk_bf16_f32 v231, v102, v103
    ds_write_b64 v13, v[230:231] offset:4000
    v_mfma_f32_16x16x32_bf16 v[88:91], v[172:175], v[208:211], v[88:91]
    v_cvt_pk_bf16_f32 v232, v116, v117
    v_cvt_pk_bf16_f32 v233, v118, v119
    v_mfma_f32_16x16x32_bf16 v[104:107], v[176:179], v[208:211], v[104:107]
    ds_write_b64 v13, v[232:233] offset:4032
    v_mfma_f32_16x16x32_bf16 v[120:123], v[180:183], v[208:211], v[120:123]
    s_waitcnt lgkmcnt(0)
    s_barrier
    v_mfma_f32_16x16x32_bf16 v[28:31], v[128:131], v[196:199], v[28:31]
    v_mfma_f32_16x16x32_bf16 v[44:47], v[132:135], v[196:199], v[44:47]
    v_mfma_f32_16x16x32_bf16 v[60:63], v[136:139], v[196:199], v[60:63]
    v_cvt_pk_bf16_f32 v220, v24, v25
    v_cvt_pk_bf16_f32 v221, v26, v27
    v_mfma_f32_16x16x32_bf16 v[76:79], v[140:143], v[196:199], v[76:79]
    ds_write_b64 v13, v[220:221] offset:7680
    v_cvt_pk_bf16_f32 v222, v40, v41
    v_mfma_f32_16x16x32_bf16 v[92:95], v[144:147], v[196:199], v[92:95]
    v_cvt_pk_bf16_f32 v223, v42, v43
    ds_write_b64 v13, v[222:223] offset:7712
    v_mfma_f32_16x16x32_bf16 v[108:111], v[148:151], v[196:199], v[108:111]
    v_cvt_pk_bf16_f32 v224, v56, v57
    v_cvt_pk_bf16_f32 v225, v58, v59
    v_mfma_f32_16x16x32_bf16 v[124:127], v[152:155], v[196:199], v[124:127]
    ds_write_b64 v13, v[224:225] offset:7744
    v_cvt_pk_bf16_f32 v226, v72, v73
    v_mfma_f32_16x16x32_bf16 v[28:31], v[156:159], v[212:215], v[28:31]
    v_cvt_pk_bf16_f32 v227, v74, v75
    ds_write_b64 v13, v[226:227] offset:7776
    v_mfma_f32_16x16x32_bf16 v[44:47], v[160:163], v[212:215], v[44:47]
    v_cvt_pk_bf16_f32 v228, v88, v89
    v_cvt_pk_bf16_f32 v229, v90, v91
    v_mfma_f32_16x16x32_bf16 v[60:63], v[164:167], v[212:215], v[60:63]
    ds_write_b64 v13, v[228:229] offset:7808
    v_cvt_pk_bf16_f32 v230, v104, v105
    v_mfma_f32_16x16x32_bf16 v[76:79], v[168:171], v[212:215], v[76:79]
    v_cvt_pk_bf16_f32 v231, v106, v107
    ds_write_b64 v13, v[230:231] offset:7840
    v_mfma_f32_16x16x32_bf16 v[92:95], v[172:175], v[212:215], v[92:95]
    v_cvt_pk_bf16_f32 v232, v120, v121
    v_cvt_pk_bf16_f32 v233, v122, v123
    v_mfma_f32_16x16x32_bf16 v[108:111], v[176:179], v[212:215], v[108:111]
    ds_write_b64 v13, v[232:233] offset:7872
    v_mfma_f32_16x16x32_bf16 v[124:127], v[180:183], v[212:215], v[124:127]
    s_waitcnt lgkmcnt(0)
    s_barrier
    s_nop 7
    v_cvt_pk_bf16_f32 v220, v28, v29
    v_cvt_pk_bf16_f32 v221, v30, v31
    ds_write_b64 v13, v[220:221] offset:11520
    v_cvt_pk_bf16_f32 v222, v44, v45
    v_cvt_pk_bf16_f32 v223, v46, v47
    ds_write_b64 v13, v[222:223] offset:11552
    v_cvt_pk_bf16_f32 v224, v60, v61
    v_cvt_pk_bf16_f32 v225, v62, v63
    ds_write_b64 v13, v[224:225] offset:11584
    v_cvt_pk_bf16_f32 v226, v76, v77
    v_cvt_pk_bf16_f32 v227, v78, v79
    ds_write_b64 v13, v[226:227] offset:11616
    v_cvt_pk_bf16_f32 v228, v92, v93
    v_cvt_pk_bf16_f32 v229, v94, v95
    ds_write_b64 v13, v[228:229] offset:11648
    v_cvt_pk_bf16_f32 v230, v108, v109
    v_cvt_pk_bf16_f32 v231, v110, v111
    ds_write_b64 v13, v[230:231] offset:11680
    v_cvt_pk_bf16_f32 v232, v124, v125
    v_cvt_pk_bf16_f32 v233, v126, v127
    ds_write_b64 v13, v[232:233] offset:11712
    s_waitcnt lgkmcnt(0)
    s_barrier
    s_branch L_fin
L_prod:
    buffer_load_dword v238, v241, s[84:87], 0 offen sc1
    s_add_u32 s24, s38, s28
    s_add_u32 m0, s24, 0
    s_nop 0
    buffer_load_dwordx4 v16, s[4:7], s29 offen offset:0 lds
    buffer_load_dwordx4 v17, s[4:7], s29 offen offset:1024 lds
    buffer_load_dwordx4 v18, s[4:7], s29 offen offset:2048 lds
    buffer_load_dwordx4 v19, s[4:7], s29 offen offset:3072 lds
    s_add_u32 m0, s24, 4096
    s_nop 0
    buffer_load_dwordx4 v20, s[4:7], s29 offen offset:0 lds
    buffer_load_dwordx4 v21, s[4:7], s29 offen offset:1024 lds
    buffer_load_dwordx4 v22, s[4:7], s29 offen offset:2048 lds
    buffer_load_dwordx4 v23, s[4:7], s29 offen offset:3072 lds
    v_min_u32 v84, 15, v77
    s_lshl_b32 s24, s33, 4
    v_add_u32 v84, s24, v84
    v_lshl_add_u32 v84, v84, 2, v78
    v_lshlrev_b32 v84, 7, v84
    v_add_u32 v237, 8388608, v84
    s_mov_b32 s68, 0
    s_mov_b32 s69, 0
    s_waitcnt vmcnt(8)
    v_readfirstlane_b32 s82, v238
    s_cmp_lg_u32 s82, 0
    s_cbranch_scc1 L_n_gotp
    s_mov_b32 s81, 0
L_n_pollp:
    buffer_load_dword v238, v241, s[84:87], 0 offen sc1
    s_waitcnt vmcnt(0)
    v_readfirstlane_b32 s82, v238
    s_cmp_lg_u32 s82, 0
    s_cbranch_scc1 L_n_gotp
    s_sleep 2
    s_add_u32 s81, s81, 1
    s_cmp_lt_u32 s81, 64
    s_cbranch_scc1 L_n_pollp
L_n_gotp:
    s_mov_b32 s98, s97
    s_mov_b32 s96, 2
    s_add_u32 s97, s97, 2
    s_and_b32 s97, s97, 15
    s_mov_b32 s94, 65536
    s_mov_b32 s95, 28672
    s_barrier
L_ploop:
    s_bitcmp1_b32 s68, s97
    s_cbranch_scc1 L_rdyL
    s_cmp_eq_u32 s82, 0
    s_cbranch_scc1 L_fbL
    s_mov_b32 s81, s69
L_pollL:
    buffer_load_dword v239, v237, s[64:67], 0 offen sc1
    s_waitcnt vmcnt(0)
    v_cmp_eq_u32 vcc, v239, v238
    s_mov_b32 s68, vcc_lo
    s_bitcmp1_b32 s68, s97
    s_cbranch_scc1 L_rdyL
    s_sleep 2
    s_add_u32 s81, s81, 1
    s_cmp_lt_u32 s81, 64
    s_cbranch_scc1 L_pollL
L_fbL:
    s_mov_b32 s69, 64
    s_mul_i32 s78, s97, 917504
    s_mov_b32 s79, s95
    s_lshr_b32 s24, s97, 1
    s_mul_i32 s80, s24, 7168
    buffer_load_dwordx2 v[96:97], v92, s[16:19], s80 offen
    buffer_load_dwordx2 v[98:99], v92, s[20:23], s80 offen
    buffer_load_dwordx4 v[100:103], v24, s[8:11], s78 offen
    buffer_load_dwordx4 v[104:107], v25, s[8:11], s78 offen
    buffer_load_dwordx4 v[108:111], v26, s[8:11], s78 offen
    buffer_load_dwordx4 v[112:115], v27, s[8:11], s78 offen
    buffer_load_dwordx4 v[116:119], v28, s[8:11], s78 offen
    buffer_load_dwordx4 v[120:123], v29, s[8:11], s78 offen
    buffer_load_dwordx4 v[124:127], v30, s[8:11], s78 offen
    buffer_load_dwordx4 v[128:131], v31, s[8:11], s78 offen
    s_waitcnt vmcnt(0)
    s_call_b64 s[76:77], L_dq
    s_branch L_doneL
L_rdyL:
    s_mul_i32 s27, s97, 14336
    s_add_u32 s27, s27, s70
    s_add_u32 m0, s71, s95
    s_nop 0
    buffer_load_dwordx4 v236, s[64:67], s27 offen offset:0 sc1 lds
    buffer_load_dwordx4 v236, s[64:67], s27 offen offset:1024 sc1 lds
    buffer_load_dwordx4 v236, s[64:67], s27 offen offset:2048 sc1 lds
    s_mov_b32 exec_hi, 0
    buffer_load_dwordx4 v236, s[64:67], s27 offen offset:3072 sc1 lds
    s_mov_b32 exec_hi, -1
L_doneL:
    s_lshl_b32 s29, s97, 7
    s_add_u32 s24, s38, s94
    s_add_u32 m0, s24, 0
    s_nop 0
    buffer_load_dwordx4 v16, s[4:7], s29 offen offset:0 lds
    buffer_load_dwordx4 v17, s[4:7], s29 offen offset:1024 lds
    buffer_load_dwordx4 v18, s[4:7], s29 offen offset:2048 lds
    buffer_load_dwordx4 v19, s[4:7], s29 offen offset:3072 lds
    s_add_u32 m0, s24, 4096
    s_nop 0
    buffer_load_dwordx4 v20, s[4:7], s29 offen offset:0 lds
    buffer_load_dwordx4 v21, s[4:7], s29 offen offset:1024 lds
    buffer_load_dwordx4 v22, s[4:7], s29 offen offset:2048 lds
    buffer_load_dwordx4 v23, s[4:7], s29 offen offset:3072 lds
    s_add_u32 s94, s94, 32768
    s_cmp_eq_u32 s94, 98304
    s_cselect_b32 s94, 0, s94
    s_add_u32 s95, s95, 14336
    s_cmp_eq_u32 s95, 57344
    s_cselect_b32 s95, 0, s95
    s_add_u32 s97, s97, 2
    s_and_b32 s97, s97, 15
    s_add_u32 s24, s97, 3
    s_and_b32 s24, s24, 15
    s_cmp_eq_u32 s97, s98
    s_cselect_b32 s97, s24, s97
    s_waitcnt vmcnt(12)
    s_cmp_lg_u32 s96, 2
    s_cbranch_scc1 L_noso
    ds_read_b128 v[40:43], v90 offset:0
    ds_read_b128 v[44:47], v90 offset:1024
    ds_read_b128 v[48:51], v90 offset:2048
    ds_read_b128 v[52:55], v90 offset:3072
    s_waitcnt lgkmcnt(3)
    buffer_store_dwordx4 v[40:43], v236, s[64:67], s30 offen offset:0 sc1
    s_waitcnt lgkmcnt(2)
    buffer_store_dwordx4 v[44:47], v236, s[64:67], s30 offen offset:1024 sc1
    s_waitcnt lgkmcnt(1)
    buffer_store_dwordx4 v[48:51], v236, s[64:67], s30 offen offset:2048 sc1
    s_waitcnt lgkmcnt(0)
    s_mov_b32 exec_hi, 0
    buffer_store_dwordx4 v[52:55], v236, s[64:67], s30 offen offset:3072 sc1
    s_mov_b32 exec_hi, -1
L_noso:
    s_cmp_lg_u32 s96, 3
    s_cbranch_scc1 L_nofl
    s_mov_b64 exec, 1
    buffer_store_dword v238, v240, s[64:67], s74 offen sc1
    s_mov_b64 exec, -1
L_nofl:
    s_add_u32 s96, s96, 1
    s_cmp_lt_u32 s96, 16
    s_barrier
    s_cbranch_scc1 L_ploop
    s_waitcnt vmcnt(0)
    s_barrier
    v_and_b32 v10, 63, v0
    v_mul_u32_u24 v11, 0x1250, v10
    v_lshrrev_b32 v11, 16, v11
    v_mul_u32_u24 v12, 14, v11
    v_sub_u32 v12, v10, v12
    v_and_b32 v13, 3, v1
    v_lshl_add_u32 v13, v13, 6, v11
    s_mov_b32 s27, 240
    v_mul_lo_u32 v14, v13, s27
    v_lshl_add_u32 v14, v12, 4, v14
    v_add_u32 v14, 32768, v14
    v_add_u32 v13, s35, v13
    s_mov_b32 s27, 7168
    v_mul_lo_u32 v13, v13, s27
    s_lshl_b32 s28, s36, 1
    v_lshl_add_u32 v13, v12, 4, v13
    v_add_u32 v13, s28, v13
    v_cmp_gt_u32 vcc, 56, v10
    s_and_b64 exec, exec, vcc
    s_barrier
    ds_read_b128 v[128:131], v14 offset:0
    ds_read_b128 v[132:135], v14 offset:960
    ds_read_b128 v[136:139], v14 offset:1920
    ds_read_b128 v[140:143], v14 offset:2880
    s_mov_b32 s24, 0
    s_waitcnt lgkmcnt(3)
    buffer_store_dwordx4 v[128:131], v13, s[12:15], s24 offen
    s_mov_b32 s24, 28672
    s_waitcnt lgkmcnt(2)
    buffer_store_dwordx4 v[132:135], v13, s[12:15], s24 offen
    s_mov_b32 s24, 57344
    s_waitcnt lgkmcnt(1)
    buffer_store_dwordx4 v[136:139], v13, s[12:15], s24 offen
    s_mov_b32 s24, 86016
    s_waitcnt lgkmcnt(0)
    buffer_store_dwordx4 v[140:143], v13, s[12:15], s24 offen
    s_barrier
    ds_read_b128 v[144:147], v14 offset:3840
    ds_read_b128 v[148:151], v14 offset:4800
    ds_read_b128 v[152:155], v14 offset:5760
    ds_read_b128 v[156:159], v14 offset:6720
    s_mov_b32 s24, 114688
    s_waitcnt lgkmcnt(3)
    buffer_store_dwordx4 v[144:147], v13, s[12:15], s24 offen
    s_mov_b32 s24, 143360
    s_waitcnt lgkmcnt(2)
    buffer_store_dwordx4 v[148:151], v13, s[12:15], s24 offen
    s_mov_b32 s24, 172032
    s_waitcnt lgkmcnt(1)
    buffer_store_dwordx4 v[152:155], v13, s[12:15], s24 offen
    s_mov_b32 s24, 200704
    s_waitcnt lgkmcnt(0)
    buffer_store_dwordx4 v[156:159], v13, s[12:15], s24 offen
    s_barrier
    ds_read_b128 v[160:163], v14 offset:7680
    ds_read_b128 v[164:167], v14 offset:8640
    ds_read_b128 v[168:171], v14 offset:9600
    ds_read_b128 v[172:175], v14 offset:10560
    s_mov_b32 s24, 229376
    s_waitcnt lgkmcnt(3)
    buffer_store_dwordx4 v[160:163], v13, s[12:15], s24 offen
    s_mov_b32 s24, 258048
    s_waitcnt lgkmcnt(2)
    buffer_store_dwordx4 v[164:167], v13, s[12:15], s24 offen
    s_mov_b32 s24, 286720
    s_waitcnt lgkmcnt(1)
    buffer_store_dwordx4 v[168:171], v13, s[12:15], s24 offen
    s_mov_b32 s24, 315392
    s_waitcnt lgkmcnt(0)
    buffer_store_dwordx4 v[172:175], v13, s[12:15], s24 offen
    s_barrier
    ds_read_b128 v[176:179], v14 offset:11520
    ds_read_b128 v[180:183], v14 offset:12480
    ds_read_b128 v[184:187], v14 offset:13440
    ds_read_b128 v[188:191], v14 offset:14400
    s_mov_b32 s24, 344064
    s_waitcnt lgkmcnt(3)
    buffer_store_dwordx4 v[176:179], v13, s[12:15], s24 offen
    s_mov_b32 s24, 372736
    s_waitcnt lgkmcnt(2)
    buffer_store_dwordx4 v[180:183], v13, s[12:15], s24 offen
    s_mov_b32 s24, 401408
    s_waitcnt lgkmcnt(1)
    buffer_store_dwordx4 v[184:187], v13, s[12:15], s24 offen
    s_mov_b32 s24, 430080
    s_waitcnt lgkmcnt(0)
    buffer_store_dwordx4 v[188:191], v13, s[12:15], s24 offen
    s_mov_b64 exec, -1
    s_branch L_fin
L_dq:
    v_add_u32 v84, s79, v60
    v_add_u32 v85, s79, v61
    v_add_u32 v86, s79, v62
    v_add_u32 v87, s79, v63
    v_lshlrev_b32 v32, 16, v96
    v_and_b32 v33, 0xffff0000, v96
    v_lshlrev_b32 v34, 16, v97
    v_and_b32 v35, 0xffff0000, v97
    v_lshlrev_b32 v36, 16, v98
    v_and_b32 v37, 0xffff0000, v98
    v_lshlrev_b32 v38, 16, v99
    v_and_b32 v39, 0xffff0000, v99
    v_fma_mix_f32 v100, v100, s34, -v36 op_sel_hi:[1,0,0]
    v_fma_mix_f32 v104, v104, s34, -v36 op_sel_hi:[1,0,0]
    v_fma_mix_f32 v108, v108, s34, -v36 op_sel_hi:[1,0,0]
    v_fma_mix_f32 v112, v112, s34, -v36 op_sel_hi:[1,0,0]
    v_fma_mix_f32 v116, v116, s34, -v36 op_sel_hi:[1,0,0]
    v_fma_mix_f32 v120, v120, s34, -v36 op_sel_hi:[1,0,0]
    v_fma_mix_f32 v124, v124, s34, -v36 op_sel_hi:[1,0,0]
    v_fma_mix_f32 v128, v128, s34, -v36 op_sel_hi:[1,0,0]
    v_cvt_pk_bf16_f32 v40, v100, v104
    v_cvt_pk_bf16_f32 v41, v108, v112
    v_cvt_pk_bf16_f32 v42, v116, v120
    v_cvt_pk_bf16_f32 v43, v124, v128
    v_lshlrev_b32 v100, 16, v40
    v_and_b32 v104, 0xffff0000, v40
    v_lshlrev_b32 v108, 16, v41
    v_and_b32 v112, 0xffff0000, v41
    v_lshlrev_b32 v116, 16, v42
    v_and_b32 v120, 0xffff0000, v42
    v_lshlrev_b32 v124, 16, v43
    v_and_b32 v128, 0xffff0000, v43
    v_mul_f32 v100, v100, v32
    v_mul_f32 v104, v104, v32
    v_mul_f32 v108, v108, v32
    v_mul_f32 v112, v112, v32
    v_mul_f32 v116, v116, v32
    v_mul_f32 v120, v120, v32
    v_mul_f32 v124, v124, v32
    v_mul_f32 v128, v128, v32
    v_cvt_pk_bf16_f32 v40, v100, v104
    v_cvt_pk_bf16_f32 v41, v108, v112
    v_cvt_pk_bf16_f32 v42, v116, v120
    v_cvt_pk_bf16_f32 v43, v124, v128
    ds_write_b128 v84, v[40:43]
    v_fma_mix_f32 v101, v101, s34, -v37 op_sel_hi:[1,0,0]
    v_fma_mix_f32 v105, v105, s34, -v37 op_sel_hi:[1,0,0]
    v_fma_mix_f32 v109, v109, s34, -v37 op_sel_hi:[1,0,0]
    v_fma_mix_f32 v113, v113, s34, -v37 op_sel_hi:[1,0,0]
    v_fma_mix_f32 v117, v117, s34, -v37 op_sel_hi:[1,0,0]
    v_fma_mix_f32 v121, v121, s34, -v37 op_sel_hi:[1,0,0]
    v_fma_mix_f32 v125, v125, s34, -v37 op_sel_hi:[1,0,0]
    v_fma_mix_f32 v129, v129, s34, -v37 op_sel_hi:[1,0,0]
    v_cvt_pk_bf16_f32 v44, v101, v105
    v_cvt_pk_bf16_f32 v45, v109, v113
    v_cvt_pk_bf16_f32 v46, v117, v121
    v_cvt_pk_bf16_f32 v47, v125, v129
    v_lshlrev_b32 v101, 16, v44
    v_and_b32 v105, 0xffff0000, v44
    v_lshlrev_b32 v109, 16, v45
    v_and_b32 v113, 0xffff0000, v45
    v_lshlrev_b32 v117, 16, v46
    v_and_b32 v121, 0xffff0000, v46
    v_lshlrev_b32 v125, 16, v47
    v_and_b32 v129, 0xffff0000, v47
    v_mul_f32 v101, v101, v33
    v_mul_f32 v105, v105, v33
    v_mul_f32 v109, v109, v33
    v_mul_f32 v113, v113, v33
    v_mul_f32 v117, v117, v33
    v_mul_f32 v121, v121, v33
    v_mul_f32 v125, v125, v33
    v_mul_f32 v129, v129, v33
    v_cvt_pk_bf16_f32 v44, v101, v105
    v_cvt_pk_bf16_f32 v45, v109, v113
    v_cvt_pk_bf16_f32 v46, v117, v121
    v_cvt_pk_bf16_f32 v47, v125, v129
    ds_write_b128 v85, v[44:47]
    v_fma_mix_f32 v102, v102, s34, -v38 op_sel_hi:[1,0,0]
    v_fma_mix_f32 v106, v106, s34, -v38 op_sel_hi:[1,0,0]
    v_fma_mix_f32 v110, v110, s34, -v38 op_sel_hi:[1,0,0]
    v_fma_mix_f32 v114, v114, s34, -v38 op_sel_hi:[1,0,0]
    v_fma_mix_f32 v118, v118, s34, -v38 op_sel_hi:[1,0,0]
    v_fma_mix_f32 v122, v122, s34, -v38 op_sel_hi:[1,0,0]
    v_fma_mix_f32 v126, v126, s34, -v38 op_sel_hi:[1,0,0]
    v_fma_mix_f32 v130, v130, s34, -v38 op_sel_hi:[1,0,0]
    v_cvt_pk_bf16_f32 v48, v102, v106
    v_cvt_pk_bf16_f32 v49, v110, v114
    v_cvt_pk_bf16_f32 v50, v118, v122
    v_cvt_pk_bf16_f32 v51, v126, v130
    v_lshlrev_b32 v102, 16, v48
    v_and_b32 v106, 0xffff0000, v48
    v_lshlrev_b32 v110, 16, v49
    v_and_b32 v114, 0xffff0000, v49
    v_lshlrev_b32 v118, 16, v50
    v_and_b32 v122, 0xffff0000, v50
    v_lshlrev_b32 v126, 16, v51
    v_and_b32 v130, 0xffff0000, v51
    v_mul_f32 v102, v102, v34
    v_mul_f32 v106, v106, v34
    v_mul_f32 v110, v110, v34
    v_mul_f32 v114, v114, v34
    v_mul_f32 v118, v118, v34
    v_mul_f32 v122, v122, v34
    v_mul_f32 v126, v126, v34
    v_mul_f32 v130, v130, v34
    v_cvt_pk_bf16_f32 v48, v102, v106
    v_cvt_pk_bf16_f32 v49, v110, v114
    v_cvt_pk_bf16_f32 v50, v118, v122
    v_cvt_pk_bf16_f32 v51, v126, v130
    ds_write_b128 v86, v[48:51]
    v_fma_mix_f32 v103, v103, s34, -v39 op_sel_hi:[1,0,0]
    v_fma_mix_f32 v107, v107, s34, -v39 op_sel_hi:[1,0,0]
    v_fma_mix_f32 v111, v111, s34, -v39 op_sel_hi:[1,0,0]
    v_fma_mix_f32 v115, v115, s34, -v39 op_sel_hi:[1,0,0]
    v_fma_mix_f32 v119, v119, s34, -v39 op_sel_hi:[1,0,0]
    v_fma_mix_f32 v123, v123, s34, -v39 op_sel_hi:[1,0,0]
    v_fma_mix_f32 v127, v127, s34, -v39 op_sel_hi:[1,0,0]
    v_fma_mix_f32 v131, v131, s34, -v39 op_sel_hi:[1,0,0]
    v_cvt_pk_bf16_f32 v52, v103, v107
    v_cvt_pk_bf16_f32 v53, v111, v115
    v_cvt_pk_bf16_f32 v54, v119, v123
    v_cvt_pk_bf16_f32 v55, v127, v131
    v_lshlrev_b32 v103, 16, v52
    v_and_b32 v107, 0xffff0000, v52
    v_lshlrev_b32 v111, 16, v53
    v_and_b32 v115, 0xffff0000, v53
    v_lshlrev_b32 v119, 16, v54
    v_and_b32 v123, 0xffff0000, v54
    v_lshlrev_b32 v127, 16, v55
    v_and_b32 v131, 0xffff0000, v55
    v_mul_f32 v103, v103, v35
    v_mul_f32 v107, v107, v35
    v_mul_f32 v111, v111, v35
    v_mul_f32 v115, v115, v35
    v_mul_f32 v119, v119, v35
    v_mul_f32 v123, v123, v35
    v_mul_f32 v127, v127, v35
    v_mul_f32 v131, v131, v35
    v_cvt_pk_bf16_f32 v52, v103, v107
    v_cvt_pk_bf16_f32 v53, v111, v115
    v_cvt_pk_bf16_f32 v54, v119, v123
    v_cvt_pk_bf16_f32 v55, v127, v131
    ds_write_b128 v87, v[52:55]
    s_waitcnt lgkmcnt(0)
    s_setpc_b64 s[76:77]
L_fin:
L_end:
    s_endpgm
.section .rodata,"a"
.p2align 6
.amdhsa_kernel standalone__w4a16_gemm_dequant__prompt_kernel
  .amdhsa_next_free_vgpr 256
  .amdhsa_next_free_sgpr 102
  .amdhsa_accum_offset 256
  .amdhsa_group_segment_fixed_size 0
  .amdhsa_kernarg_size 56
  .amdhsa_user_sgpr_count 2
  .amdhsa_user_sgpr_kernarg_segment_ptr 1
  .amdhsa_system_sgpr_workgroup_id_x 1
  .amdhsa_float_denorm_mode_32 3
  .amdhsa_float_denorm_mode_16_64 3
.end_amdhsa_kernel
```
